```python
import torch

def _softmax(x, axis=-1):
    return torch.softmax(x, dim=axis)
def _gelu(x):
    return torch.nn.functional.gelu(x, approximate="tanh")
def _silu(x):
    return torch.nn.functional.silu(x)
def _sigmoid(x):
    return torch.sigmoid(x)
def _layernorm(x, axis=-1, eps=1e-5):
    m = x.mean(dim=axis, keepdim=True)
    v = x.var(dim=axis, keepdim=True, unbiased=False)
    return (x - m) / torch.sqrt(v + eps)
def _scatter_add(tgt, idx, src, axis=0):
    return tgt.clone().index_add_(axis, idx, src)
def _segment_sum(src, seg, n):
    out = torch.zeros((n,) + src.shape[1:], dtype=src.dtype)
    return out.index_add_(0, seg, src)
def _pad(x, pw):
    flat = tuple(v for pair in reversed(pw) for v in pair)
    return torch.nn.functional.pad(x, flat)

kernel_name = 'standalone__paged_block_table_kv_pagedattention__sampling'

def setup_inputs():

    _w = (lambda a: (lambda t: t.to(torch.bfloat16) if t.is_floating_point() else t)(torch.as_tensor(a)))
    B, Hq, Hkv, Sq, Skv, D = 32, 32, 8, 8, 2048, 128
    bs = 16
    nbps = max(1, Skv // bs)
    num_phys = B * nbps + 4
    bt = torch.randperm(num_phys)[: B * nbps].reshape(B, nbps).to(torch.int64)
    cl = (nbps * bs - (torch.arange(1, B + 1, dtype=torch.int64) * 2654435761) % max(1, nbps * bs // 2)).to(torch.int64)
    return {
        "q": _w((lambda *s: torch.randn(*s, dtype=torch.bfloat16) * 0.8)(B, Hq, Sq, D)),
        "k_cache": _w((lambda *s: torch.randn(*s, dtype=torch.bfloat16) * 0.8)(num_phys, bs, Hkv, D)),
        "v_cache": _w((lambda *s: torch.randn(*s, dtype=torch.bfloat16) * 0.05)(num_phys, bs, Hkv, D)),
        "block_table": _w(bt),
        "context_lens": _w(cl),
    }

def reference(q, k_cache, v_cache, block_table, context_lens):
    B, Hq, Sq, D = q.shape
    bs = k_cache.shape[1]
    Hkv = k_cache.shape[2]
    nbps = block_table.shape[1]
    Skv = nbps * bs
    bt = block_table.reshape(-1)
    k = (lambda x, *d: x.permute(*d))(k_cache[bt].reshape(B, Skv, Hkv, D), 0, 2, 1, 3)
    v = (lambda x, *d: x.permute(*d))(v_cache[bt].reshape(B, Skv, Hkv, D), 0, 2, 1, 3)
    g = Hq // Hkv
    qg = q.reshape(B, Hkv, g, Sq, D)
    scores = torch.einsum("bhgqd,bhkd->bhgqk", qg, k) * (D ** -0.5)
    pos = torch.arange(Skv)
    msk = pos[None, :] < context_lens[:, None]
    scores = torch.where(msk[:, None, None, None, :], scores, -1e9)
    p = _softmax(scores, axis=-1)
    out = torch.einsum("bhgqk,bhkd->bhgqd", p, v)
    return out.reshape(B, Hq, Sq, D)
```

```asm
; @launch grid=(256,1,1) block=(384,1,1) lds=163328
.amdgcn_target "amdgcn-amd-amdhsa--gfx950"
.text
.globl standalone__paged_block_table_kv_pagedattention__sampling_kernel
.p2align 8
.type standalone__paged_block_table_kv_pagedattention__sampling_kernel,@function
standalone__paged_block_table_kv_pagedattention__sampling_kernel:
    s_load_dwordx16 s[4:19], s[0:1], 0
    s_lshr_b32 s28, s2, 3
    s_cmp_ge_u32 s28, 32
    s_cbranch_scc1 L_end
    v_lshrrev_b32 v2, 6, v0
    v_and_b32 v1, 63, v0
    v_readfirstlane_b32 s30, v2
    s_getpc_b64 s[36:37]
L_pc:
    v_lshlrev_b32 v4, 7, v1
    v_min_u32 v4, L_end - L_pc - 256, v4
    s_cmp_lg_u32 s30, 1
    s_cbranch_scc1 L_nopf
    global_load_dword v61, v4, s[36:37] offset:256
L_nopf:
    v_mov_b64 v[4:5], 0
    v_lshlrev_b32 v6, 3, v0
    v_add_u32 v6, 160000, v6
    ds_write_b64 v6, v[4:5]
    s_and_b32 s29, s2, 7
    s_lshl3_add_u32 s34, s28, s29
    s_lshl_b32 s34, s34, 13
    v_lshl_add_u32 v7, v1, 7, s34
    s_lshl_b32 s32, s28, 9
    v_lshl_add_u32 v4, v1, 3, s32
    v_and_b32 v2, 31, v1
    v_lshlrev_b32 v5, 2, v2
    s_cmp_lg_u32 s30, 2
    s_waitcnt lgkmcnt(0)
    s_load_dwordx8 s[72:79], s[10:11], s32
    s_cbranch_scc1 L_noq
    global_load_dword v61, v7, s[4:5]
L_noq:
    global_load_dwordx2 v[8:9], v4, s[10:11]
    global_load_dword v63, v5, s[12:13]
L_loads_issued:
    s_cmp_lg_u32 s30, 0
    s_mov_b32 s38, 4194304
    s_cbranch_scc1 L_notloader
    s_setprio 3
    v_lshrrev_b32 v21, 4, v1
    v_and_b32 v3, 15, v1
    s_lshl_b32 s32, s29, 8
    v_lshl_add_u32 v6, v21, 11, s32
    v_xor_b32 v4, v21, v3
    v_lshl_add_u32 v10, v4, 4, v6
    v_xor_b32 v5, 64, v10
    v_add_u32 v11, 7168, v5
    v_xor_b32 v5, 128, v10
    v_add_u32 v12, 14336, v5
    v_xor_b32 v5, 192, v10
    v_add_u32 v13, 21504, v5
    s_mov_b32 s20, s6
    s_and_b32 s21, s7, 0xffff
    s_mov_b32 s22, 134348800
    s_mov_b32 s23, 0x20000
    s_waitcnt lgkmcnt(0)
    s_movk_i32 m0, 0
    s_lshl_b32 s46, s72, 15
    buffer_load_dwordx4 v10, s[20:23], s46 offen offset:0 nt lds
    buffer_load_dwordx4 v11, s[20:23], s46 offen offset:1024 nt lds
    buffer_load_dwordx4 v12, s[20:23], s46 offen offset:2048 nt lds
    buffer_load_dwordx4 v13, s[20:23], s46 offen offset:3072 nt lds
    s_movk_i32 m0, 4096
    s_lshl_b32 s46, s73, 15
    buffer_load_dwordx4 v10, s[20:23], s46 offen offset:0 nt lds
    buffer_load_dwordx4 v11, s[20:23], s46 offen offset:1024 nt lds
    buffer_load_dwordx4 v12, s[20:23], s46 offen offset:2048 nt lds
    buffer_load_dwordx4 v13, s[20:23], s46 offen offset:3072 nt lds
    s_movk_i32 m0, 8192
    s_lshl_b32 s46, s74, 15
    buffer_load_dwordx4 v10, s[20:23], s46 offen offset:0 nt lds
    buffer_load_dwordx4 v11, s[20:23], s46 offen offset:1024 nt lds
    buffer_load_dwordx4 v12, s[20:23], s46 offen offset:2048 nt lds
    buffer_load_dwordx4 v13, s[20:23], s46 offen offset:3072 nt lds
    s_movk_i32 m0, 12288
    s_lshl_b32 s46, s75, 15
    buffer_load_dwordx4 v10, s[20:23], s46 offen offset:0 nt lds
    buffer_load_dwordx4 v11, s[20:23], s46 offen offset:1024 nt lds
    buffer_load_dwordx4 v12, s[20:23], s46 offen offset:2048 nt lds
    buffer_load_dwordx4 v13, s[20:23], s46 offen offset:3072 nt lds
    s_movk_i32 m0, 16384
    s_lshl_b32 s46, s76, 15
    buffer_load_dwordx4 v10, s[20:23], s46 offen offset:0 nt lds
    buffer_load_dwordx4 v11, s[20:23], s46 offen offset:1024 nt lds
    buffer_load_dwordx4 v12, s[20:23], s46 offen offset:2048 nt lds
    buffer_load_dwordx4 v13, s[20:23], s46 offen offset:3072 nt lds
    s_movk_i32 m0, 20480
    s_lshl_b32 s46, s77, 15
    buffer_load_dwordx4 v10, s[20:23], s46 offen offset:0 nt lds
    buffer_load_dwordx4 v11, s[20:23], s46 offen offset:1024 nt lds
    buffer_load_dwordx4 v12, s[20:23], s46 offen offset:2048 nt lds
    buffer_load_dwordx4 v13, s[20:23], s46 offen offset:3072 nt lds
L_ld_b:
    s_barrier
L_ld_pre:
    v_lshlrev_b32 v5, 2, v21
    v_xor_b32 v5, v5, v3
    v_lshl_add_u32 v14, v5, 4, v6
    v_add_u32 v15, 7168, v14
    v_add_u32 v16, 14336, v14
    v_add_u32 v17, 21504, v14
    v_lshlrev_b32 v18, 3, v1
    v_add_u32 v2, 160768, v18
    v_add_u32 v18, 160000, v18
    v_mov_b32 v20, 160512
    v_mov_b64 v[22:23], 0
    v_mov_b32 v46, 2
    v_mov_b32 v47, 160656
    v_bfrev_b32 v48, 1
    v_mov_b64 v[24:25], v[10:11]
    v_mov_b64 v[26:27], v[12:13]
    s_mov_b32 s49, 4
    s_mov_b32 s57, 0
    s_waitcnt vmcnt(24)
    v_readlane_b32 s31, v63, s28
    s_cmp_lt_i32 s31, 1
    s_cselect_b32 s31, 2048, s31
    s_min_i32 s31, s31, 2048
    s_add_u32 s39, s31, 15
    s_lshr_b32 s39, s39, 4
    s_add_u32 s40, s39, 1
    s_lshr_b32 s40, s40, 1
    s_sub_u32 s41, s40, 1
    s_min_u32 s41, s41, 4
    s_min_u32 s42, s41, 3
    s_lshl3_add_u32 s32, s42, 160768
    v_mov_b32 v49, s32
    s_sub_u32 s32, s42, 3
    v_mov_b32 v19, s32
    s_bfm_b64 s[34:35], s41, 0
    s_cmp_ge_u32 s41, 3
    s_cbranch_scc1 L_ld_row
    s_waitcnt vmcnt(0)
L_ld_row:
    v_lshl_or_b32 v44, v8, 15, 1
    v_lshlrev_b32 v45, 15, v9
    s_mov_b64 exec, s[34:35]
    ds_write_b64 v2, v[44:45]
    s_mov_b64 exec, -1
    ds_read_b64 v[44:45], v49
    s_lshl_b32 s52, s42, 13
    s_mov_b32 s56, s42
    s_lshl_b32 s32, s40, 5
    s_sub_u32 s32, s31, s32
    s_add_u32 s32, s32, 32
    v_sub_u32 v3, s32, v21
    v_cmp_lt_i32 s[80:81], 0, v3
    v_cmp_lt_i32 s[82:83], 4, v3
    v_cmp_lt_i32 s[84:85], 8, v3
    v_cmp_lt_i32 s[86:87], 12, v3
    v_cmp_lt_i32 s[88:89], 16, v3
    v_cmp_lt_i32 s[90:91], 20, v3
    v_cmp_lt_i32 s[92:93], 24, v3
    v_cmp_lt_i32 s[94:95], 28, v3
.p2align 3
L_ld:
    s_waitcnt lgkmcnt(0)
    v_min_i32 v2, v22, v23
    v_readfirstlane_b32 s48, v44
    v_readfirstlane_b32 s47, v45
    v_readfirstlane_b32 s32, v2
    v_readfirstlane_b32 s35, v46
    s_sub_u32 s33, s56, 5
    s_cmp_ge_i32 s32, s33
    s_cselect_b32 s32, s48, 0
    s_and_b32 s46, s48, -16
    s_and_b32 s32, s32, 3
    s_cmp_lg_u32 s32, 1
    s_cbranch_scc1 L_ld_odd
    s_cmp_lg_u32 s35, 0
    s_cbranch_scc1 L_ld_var
    s_add_u32 m0, s52, 0
    s_waitcnt vmcnt(20)
    buffer_load_dwordx4 v24, s[20:23], s46 offen offset:0 nt lds
    s_add_u32 s34, s52, 8192
    s_cmp_eq_u32 s34, 49152
    s_cselect_b32 s34, 0, s34
    s_lshr_b32 s32, s34, 10
    s_add_u32 s32, s32, 160512
    v_mov_b32 v20, s32
    s_waitcnt vmcnt(20)
    buffer_load_dwordx4 v25, s[20:23], s46 offen offset:1024 nt lds
    s_add_u32 s42, s42, 1
    s_and_b32 s32, s48, s49
    s_cselect_b32 s42, s57, s42
    s_lshl3_add_u32 s32, s42, 160768
    v_mov_b32 v49, s32
    s_add_u32 s56, s56, 1
    s_waitcnt vmcnt(20)
    buffer_load_dwordx4 v26, s[20:23], s46 offen offset:2048 nt lds
    s_waitcnt vmcnt(20)
    buffer_load_dwordx4 v27, s[20:23], s46 offen offset:3072 nt lds
    s_add_u32 m0, s52, 4096
    s_waitcnt vmcnt(20)
    buffer_load_dwordx4 v24, s[20:23], s47 offen offset:0 nt lds
    v_add_u32 v19, 1, v19
    ds_write_b32 v18, v19
    s_waitcnt vmcnt(20)
    buffer_load_dwordx4 v25, s[20:23], s47 offen offset:1024 nt lds
    s_waitcnt vmcnt(20)
    buffer_load_dwordx4 v26, s[20:23], s47 offen offset:2048 nt lds
    ds_read_b64 v[44:45], v49
    ds_read_b64 v[22:23], v20
    ds_read_b32 v46, v47
    s_mov_b32 s52, s34
    s_waitcnt vmcnt(20)
    buffer_load_dwordx4 v27, s[20:23], s47 offen offset:3072 nt lds
L_ld_next:
    s_bitcmp1_b32 s48, 2
    s_cbranch_scc0 L_ld
    s_xor_b32 s49, s49, 4
    s_cbranch_scc1 L_ld_tok
    s_mov_b32 s20, s8
    s_and_b32 s21, s9, 0xffff
    v_mov_b64 v[24:25], v[14:15]
    v_mov_b64 v[26:27], v[16:17]
    s_branch L_ld
L_ld_tok:
    s_bitcmp1_b32 s48, 3
    s_cbranch_scc0 L_ld_more
    v_add_u32 v19, 1, v19
    s_waitcnt vmcnt(16)
    ds_write_b32 v18, v19
    v_add_u32 v19, 1, v19
    s_waitcnt vmcnt(8)
    ds_write_b32 v18, v19
    v_add_u32 v19, 1, v19
    s_waitcnt vmcnt(0)
    ds_write_b32 v18, v19
    s_endpgm
L_ld_more:
    s_mov_b32 s57, s42
    s_mov_b32 s20, s6
    s_and_b32 s21, s7, 0xffff
    v_mov_b64 v[24:25], v[10:11]
    v_mov_b64 v[26:27], v[12:13]
    s_branch L_ld
L_ld_odd:
    s_cmp_eq_u32 s32, 3
    s_cbranch_scc1 L_ld_m
    ds_read_b64 v[44:45], v49
    ds_read_b64 v[22:23], v20
    s_sub_u32 s38, s38, 1
    s_cbranch_scc0 L_ld
    s_endpgm
L_ld_m:
    v_cndmask_b32 v28, v48, v24, s[80:81]
    v_cndmask_b32 v29, v48, v25, s[82:83]
    v_cndmask_b32 v30, v48, v26, s[84:85]
    v_cndmask_b32 v31, v48, v27, s[86:87]
    v_cndmask_b32 v32, v48, v24, s[88:89]
    v_cndmask_b32 v33, v48, v25, s[90:91]
    v_cndmask_b32 v34, v48, v26, s[92:93]
    v_cndmask_b32 v35, v48, v27, s[94:95]
    s_add_u32 m0, s52, 0
    s_waitcnt vmcnt(23)
    buffer_load_dwordx4 v28, s[20:23], s46 offen offset:0 nt lds
    s_add_u32 s34, s52, 8192
    s_cmp_eq_u32 s34, 49152
    s_cselect_b32 s34, 0, s34
    s_lshr_b32 s32, s34, 10
    s_add_u32 s32, s32, 160512
    v_mov_b32 v20, s32
    s_waitcnt vmcnt(23)
    buffer_load_dwordx4 v29, s[20:23], s46 offen offset:1024 nt lds
    s_add_u32 s42, s42, 1
    s_and_b32 s32, s48, s49
    s_cselect_b32 s42, s57, s42
    s_lshl3_add_u32 s32, s42, 160768
    v_mov_b32 v49, s32
    s_add_u32 s56, s56, 1
    s_waitcnt vmcnt(23)
    buffer_load_dwordx4 v30, s[20:23], s46 offen offset:2048 nt lds
    s_waitcnt vmcnt(23)
    buffer_load_dwordx4 v31, s[20:23], s46 offen offset:3072 nt lds
    s_add_u32 m0, s52, 4096
    s_waitcnt vmcnt(23)
    buffer_load_dwordx4 v32, s[20:23], s47 offen offset:0 nt lds
    s_waitcnt vmcnt(23)
    buffer_load_dwordx4 v33, s[20:23], s47 offen offset:1024 nt lds
    s_waitcnt vmcnt(23)
    buffer_load_dwordx4 v34, s[20:23], s47 offen offset:2048 nt lds
    ds_read_b64 v[44:45], v49
    ds_read_b64 v[22:23], v20
    ds_read_b32 v46, v47
    s_mov_b32 s52, s34
    s_waitcnt vmcnt(23)
    buffer_load_dwordx4 v35, s[20:23], s47 offen offset:3072 nt lds
    v_add_u32 v19, 1, v19
    ds_write_b32 v18, v19
    s_branch L_ld_next
L_ld_var:
    s_cmp_eq_u32 s35, 1
    s_cbranch_scc1 L_ld_v2
    s_cmp_eq_u32 s35, 2
    s_cbranch_scc1 L_ld_v3
    s_add_u32 m0, s52, 0
    s_waitcnt vmcnt(19)
    buffer_load_dwordx4 v24, s[20:23], s46 offen offset:0 nt lds
    s_add_u32 s34, s52, 8192
    s_cmp_eq_u32 s34, 49152
    s_cselect_b32 s34, 0, s34
    s_lshr_b32 s32, s34, 10
    s_add_u32 s32, s32, 160512
    v_mov_b32 v20, s32
    s_waitcnt vmcnt(19)
    buffer_load_dwordx4 v25, s[20:23], s46 offen offset:1024 nt lds
    s_add_u32 s42, s42, 1
    s_and_b32 s32, s48, s49
    s_cselect_b32 s42, s57, s42
    s_lshl3_add_u32 s32, s42, 160768
    v_mov_b32 v49, s32
    s_add_u32 s56, s56, 1
    s_waitcnt vmcnt(19)
    buffer_load_dwordx4 v26, s[20:23], s46 offen offset:2048 nt lds
    s_waitcnt vmcnt(19)
    buffer_load_dwordx4 v27, s[20:23], s46 offen offset:3072 nt lds
    v_add_u32 v19, 1, v19
    ds_write_b32 v18, v19
    s_add_u32 m0, s52, 4096
    s_waitcnt vmcnt(19)
    buffer_load_dwordx4 v24, s[20:23], s47 offen offset:0 nt lds
    s_waitcnt vmcnt(19)
    buffer_load_dwordx4 v25, s[20:23], s47 offen offset:1024 nt lds
    s_waitcnt vmcnt(19)
    buffer_load_dwordx4 v26, s[20:23], s47 offen offset:2048 nt lds
    ds_read_b64 v[44:45], v49
    ds_read_b64 v[22:23], v20
    ds_read_b32 v46, v47
    s_mov_b32 s52, s34
    s_waitcnt vmcnt(19)
    buffer_load_dwordx4 v27, s[20:23], s47 offen offset:3072 nt lds
    s_branch L_ld_next
L_ld_v2:
    s_add_u32 m0, s52, 0
    s_waitcnt vmcnt(21)
    buffer_load_dwordx4 v24, s[20:23], s46 offen offset:0 nt lds
    s_add_u32 s34, s52, 8192
    s_cmp_eq_u32 s34, 49152
    s_cselect_b32 s34, 0, s34
    s_lshr_b32 s32, s34, 10
    s_add_u32 s32, s32, 160512
    v_mov_b32 v20, s32
    s_waitcnt vmcnt(21)
    buffer_load_dwordx4 v25, s[20:23], s46 offen offset:1024 nt lds
    s_add_u32 s42, s42, 1
    s_and_b32 s32, s48, s49
    s_cselect_b32 s42, s57, s42
    s_lshl3_add_u32 s32, s42, 160768
    v_mov_b32 v49, s32
    s_add_u32 s56, s56, 1
    s_waitcnt vmcnt(21)
    buffer_load_dwordx4 v26, s[20:23], s46 offen offset:2048 nt lds
    s_waitcnt vmcnt(21)
    buffer_load_dwordx4 v27, s[20:23], s46 offen offset:3072 nt lds
    s_add_u32 m0, s52, 4096
    s_waitcnt vmcnt(21)
    buffer_load_dwordx4 v24, s[20:23], s47 offen offset:0 nt lds
    s_waitcnt vmcnt(21)
    buffer_load_dwordx4 v25, s[20:23], s47 offen offset:1024 nt lds
    v_add_u32 v19, 1, v19
    ds_write_b32 v18, v19
    s_waitcnt vmcnt(21)
    buffer_load_dwordx4 v26, s[20:23], s47 offen offset:2048 nt lds
    ds_read_b64 v[44:45], v49
    ds_read_b64 v[22:23], v20
    ds_read_b32 v46, v47
    s_mov_b32 s52, s34
    s_waitcnt vmcnt(21)
    buffer_load_dwordx4 v27, s[20:23], s47 offen offset:3072 nt lds
    s_branch L_ld_next
L_ld_v3:
    s_add_u32 m0, s52, 0
    s_waitcnt vmcnt(23)
    buffer_load_dwordx4 v24, s[20:23], s46 offen offset:0 nt lds
    s_add_u32 s34, s52, 8192
    s_cmp_eq_u32 s34, 49152
    s_cselect_b32 s34, 0, s34
    s_lshr_b32 s32, s34, 10
    s_add_u32 s32, s32, 160512
    v_mov_b32 v20, s32
    s_waitcnt vmcnt(23)
    buffer_load_dwordx4 v25, s[20:23], s46 offen offset:1024 nt lds
    s_add_u32 s42, s42, 1
    s_and_b32 s32, s48, s49
    s_cselect_b32 s42, s57, s42
    s_lshl3_add_u32 s32, s42, 160768
    v_mov_b32 v49, s32
    s_add_u32 s56, s56, 1
    s_waitcnt vmcnt(23)
    buffer_load_dwordx4 v26, s[20:23], s46 offen offset:2048 nt lds
    s_waitcnt vmcnt(23)
    buffer_load_dwordx4 v27, s[20:23], s46 offen offset:3072 nt lds
    s_add_u32 m0, s52, 4096
    s_waitcnt vmcnt(23)
    buffer_load_dwordx4 v24, s[20:23], s47 offen offset:0 nt lds
    s_waitcnt vmcnt(23)
    buffer_load_dwordx4 v25, s[20:23], s47 offen offset:1024 nt lds
    s_waitcnt vmcnt(23)
    buffer_load_dwordx4 v26, s[20:23], s47 offen offset:2048 nt lds
    ds_read_b64 v[44:45], v49
    ds_read_b64 v[22:23], v20
    ds_read_b32 v46, v47
    s_mov_b32 s52, s34
    s_waitcnt vmcnt(23)
    buffer_load_dwordx4 v27, s[20:23], s47 offen offset:3072 nt lds
    v_add_u32 v19, 1, v19
    ds_write_b32 v18, v19
    s_branch L_ld_next
L_notloader:
    s_cmp_ge_u32 s30, 3
    s_cbranch_scc1 L_planner
    s_sub_u32 s48, s30, 1
    s_lshl3_add_u32 s58, s28, s29
    s_lshl1_add_u32 s58, s58, s48
    s_lshl_b32 s58, s58, 12
    v_and_b32 v2, 15, v1
    v_lshrrev_b32 v60, 4, v1
    v_lshl_add_u32 v6, v2, 8, s58
    v_lshl_add_u32 v6, v60, 4, v6
    global_load_dwordx4 v[32:35], v6, s[4:5] offset:0
    global_load_dwordx4 v[36:39], v6, s[4:5] offset:64
    global_load_dwordx4 v[40:43], v6, s[4:5] offset:128
    global_load_dwordx4 v[44:47], v6, s[4:5] offset:192
    s_barrier
    s_mov_b32 s57, 0
    s_mov_b32 s59, 0
    s_mov_b32 s52, 0
    s_waitcnt vmcnt(4) lgkmcnt(0)
    v_readlane_b32 s31, v63, s28
    s_cmp_lt_i32 s31, 1
    s_cselect_b32 s35, 1, 0
    s_cselect_b32 s31, 2048, s31
    s_min_i32 s31, s31, 2048
    s_add_u32 s39, s31, 15
    s_lshr_b32 s39, s39, 4
    s_add_u32 s40, s39, 1
    s_lshr_b32 s40, s40, 1
    s_sub_u32 s41, s40, 1
    s_min_u32 s41, s41, 4
    s_lshl_b32 s61, s40, 5
    s_sub_u32 s61, s31, s61
    s_add_u32 s61, s61, 32
    s_bfm_b64 s[46:47], s41, 0
L_csetup:
    s_mov_b32 s56, 0
    s_mov_b32 s20, 0
    s_mov_b32 s21, 0
    s_mov_b32 s44, 1
    s_mov_b64 s[26:27], 0
    s_waitcnt vmcnt(4)
    v_and_b32 v2, 15, v1
    v_xor_b32 v3, v60, v2
    v_lshlrev_b32 v4, 8, v2
    v_lshl_add_u32 v8, v3, 4, v4
    v_xor_b32 v9, 64, v8
    v_xor_b32 v10, 128, v8
    v_xor_b32 v11, 192, v8
    v_bfe_u32 v2, v1, 2, 2
    v_lshl_add_u32 v3, v60, 2, v2
    v_lshlrev_b32 v3, 8, v3
    v_and_b32 v4, 3, v1
    v_lshl_add_u32 v3, v4, 4, v3
    v_lshl_add_u32 v12, v2, 6, v3
    v_xor_b32 v13, 64, v12
    v_xor_b32 v14, 128, v12
    v_xor_b32 v15, 192, v12
    s_lshl_b32 s32, s48, 10
    s_add_u32 s32, s32, 49152
    v_lshl_add_u32 v20, v1, 4, s32
    v_mov_b32 v23, v6
    s_lshl_b32 s32, s30, 3
    s_add_u32 s32, s32, 159992
    v_mov_b32 v28, s32
    v_mov_b32 v24, 0xff800000
    v_mov_b32 v25, 0
    v_mov_b64 v[128:129], 0
    v_mov_b64 v[130:131], 0
    v_mov_b64 v[132:133], 0
    v_mov_b64 v[134:135], 0
    v_mov_b64 v[136:137], 0
    v_mov_b64 v[138:139], 0
    v_mov_b64 v[140:141], 0
    v_mov_b64 v[142:143], 0
    v_mov_b64 v[144:145], 0
    v_mov_b64 v[146:147], 0
    v_mov_b64 v[148:149], 0
    v_mov_b64 v[150:151], 0
    v_mov_b64 v[152:153], 0
    v_mov_b64 v[154:155], 0
    v_mov_b64 v[156:157], 0
    v_mov_b64 v[158:159], 0
    s_mov_b32 s62, 0x3e0293ee
    s_mov_b32 s63, 0x3e0293ee
    s_mov_b32 s53, 0x43800000
    s_lshl2_add_u32 s99, s48, 160512
    s_waitcnt vmcnt(0)
    s_cmp_eq_u32 s35, 0
    s_cbranch_scc1 L_k_first
    v_mov_b64 v[32:33], 0
    v_mov_b64 v[34:35], 0
    v_mov_b64 v[36:37], 0
    v_mov_b64 v[38:39], 0
    v_mov_b64 v[40:41], 0
    v_mov_b64 v[42:43], 0
    v_mov_b64 v[44:45], 0
    v_mov_b64 v[46:47], 0
L_k_first:
    s_ff1_i32_b64 s96, s[46:47]
    s_bitset0_b64 s[46:47], s96
    s_add_u32 s33, s96, s20
    s_mul_i32 s32, s33, 43
    s_lshr_b32 s32, s32, 8
    s_mul_i32 s32, s32, 6
    s_sub_u32 s32, s33, s32
    s_lshl_b32 s60, s32, 13
    s_lshl3_add_u32 s98, s32, s99
    s_and_b32 s32, s96, 0x40000000
    s_add_u32 s97, s33, 1
    s_or_b32 s97, s97, s32
    s_sub_u32 s43, s96, s21
    s_lshl_b32 s43, s43, 11
    v_add_u32 v16, s60, v8
    v_add_u32 v17, s60, v9
    v_add_u32 v18, s60, v10
    v_add_u32 v19, s60, v11
    v_mov_b32 v29, s98
    v_mov_b32 v62, s97
    v_add_u32 v21, s43, v20
    s_add_u32 s42, s96, 1
L_k_next:
    s_cmp_lt_i32 s96, 0
    s_cbranch_scc1 L_k_empty
L_k_poll:
    ds_read_b64 v[30:31], v28
    s_sub_u32 s38, s38, 1
    s_cbranch_scc1 L_end
    s_waitcnt lgkmcnt(0)
    v_readfirstlane_b32 s49, v30
    s_cmp_ge_i32 s49, s97
    s_cbranch_scc0 L_k_poll
    ds_read_b128 v[64:67], v16 offset:0
    ds_read_b128 v[68:71], v17 offset:0
    ds_read_b128 v[72:75], v18 offset:0
    ds_read_b128 v[76:79], v19 offset:0
    ds_read_b128 v[80:83], v16 offset:4096
    ds_read_b128 v[84:87], v17 offset:4096
    ds_read_b128 v[88:91], v18 offset:4096
    ds_read_b128 v[92:95], v19 offset:4096
    s_waitcnt lgkmcnt(0)
.p2align 3
L_k_top:
    s_waitcnt lgkmcnt(1)
    ds_write_b32 v29, v62
    ds_read_b64 v[30:31], v28
    v_mfma_f32_16x16x32_bf16 v[48:51], v[64:67], v[32:35], 0
    s_ff1_i32_b64 s96, s[46:47]
    s_bitset0_b64 s[46:47], s96
    v_mfma_f32_16x16x32_bf16 v[48:51], v[68:71], v[36:39], v[48:51]
    s_add_u32 s33, s96, s20
    s_mul_i32 s32, s33, 43
    v_mfma_f32_16x16x32_bf16 v[48:51], v[72:75], v[40:43], v[48:51]
    s_lshr_b32 s32, s32, 8
    s_mul_i32 s32, s32, 6
    v_mfma_f32_16x16x32_bf16 v[48:51], v[76:79], v[44:47], v[48:51]
    s_sub_u32 s32, s33, s32
    s_lshl_b32 s60, s32, 13
    v_mfma_f32_16x16x32_bf16 v[52:55], v[80:83], v[32:35], 0
    s_lshl3_add_u32 s98, s32, s99
    s_and_b32 s32, s96, 0x40000000
    v_mfma_f32_16x16x32_bf16 v[52:55], v[84:87], v[36:39], v[52:55]
    s_add_u32 s97, s33, 1
    s_or_b32 s97, s97, s32
    v_mfma_f32_16x16x32_bf16 v[52:55], v[88:91], v[40:43], v[52:55]
    s_sub_u32 s43, s96, s21
    s_lshl_b32 s43, s43, 11
    v_mfma_f32_16x16x32_bf16 v[52:55], v[92:95], v[44:47], v[52:55]
    v_add_u32 v16, s60, v8
    v_add_u32 v17, s60, v9
    v_add_u32 v18, s60, v10
    v_add_u32 v19, s60, v11
    s_mov_b32 s101, 0
    s_waitcnt lgkmcnt(0)
    v_readfirstlane_b32 s49, v30
    s_cmp_ge_i32 s49, s97
    s_cselect_b32 s100, 1, 0
    s_cbranch_scc0 L_k_nopre
    ds_read_b128 v[64:67], v16 offset:0
    ds_read_b128 v[68:71], v17 offset:0
    ds_read_b128 v[72:75], v18 offset:0
    ds_read_b128 v[76:79], v19 offset:0
    ds_read_b128 v[80:83], v16 offset:4096
    ds_read_b128 v[84:87], v17 offset:4096
    ds_read_b128 v[88:91], v18 offset:4096
    ds_read_b128 v[92:95], v19 offset:4096
L_k_nopre:
    s_cmp_eq_u32 s42, s56
    s_cbranch_scc1 L_k_mask
L_k_exp:
    v_pk_fma_f32 v[160:161], v[48:49], s[62:63], v[24:25] op_sel_hi:[1,1,0] neg_lo:[0,0,1] neg_hi:[0,0,1]
    v_pk_fma_f32 v[162:163], v[50:51], s[62:63], v[24:25] op_sel_hi:[1,1,0] neg_lo:[0,0,1] neg_hi:[0,0,1]
    v_exp_f32 v160, v160
    v_exp_f32 v161, v161
    v_exp_f32 v162, v162
    v_exp_f32 v163, v163
    v_pk_fma_f32 v[164:165], v[52:53], s[62:63], v[24:25] op_sel_hi:[1,1,0] neg_lo:[0,0,1] neg_hi:[0,0,1]
    v_pk_fma_f32 v[166:167], v[54:55], s[62:63], v[24:25] op_sel_hi:[1,1,0] neg_lo:[0,0,1] neg_hi:[0,0,1]
    v_exp_f32 v164, v164
    v_exp_f32 v165, v165
    v_exp_f32 v166, v166
    v_exp_f32 v167, v167
    v_pk_add_f32 v[2:3], v[160:161], v[162:163]
    v_pk_add_f32 v[4:5], v[164:165], v[166:167]
    v_cvt_pk_bf16_f32 v56, v160, v161
    v_pk_add_f32 v[2:3], v[2:3], v[4:5]
    v_cvt_pk_bf16_f32 v57, v162, v163
    v_add_f32 v2, v2, v3
    v_cmp_nge_f32 vcc, s53, v2
    v_cvt_pk_bf16_f32 v58, v164, v165
    v_cvt_pk_bf16_f32 v59, v166, v167
    v_mov_b32 v29, s98
    v_mov_b32 v62, s97
    s_nop 0
    s_cbranch_vccnz L_k_slow
L_k_done:
    ds_write_b128 v21, v[56:59]
    v_add_f32 v25, v25, v2
    s_add_u32 s42, s96, 1
    s_cmp_lg_u32 s100, 0
    v_add_u32 v21, s43, v20
    s_cbranch_scc1 L_k_top
    s_branch L_k_next
L_k_mask:
    v_lshlrev_b32 v2, 2, v60
    v_sub_u32 v2, s61, v2
    v_mov_b32 v3, 0xff800000
    v_cmp_lt_i32 s[80:81], 0, v2
    v_cmp_lt_i32 s[82:83], 1, v2
    v_cmp_lt_i32 s[84:85], 2, v2
    v_cmp_lt_i32 s[86:87], 3, v2
    v_cmp_lt_i32 s[88:89], 16, v2
    v_cmp_lt_i32 s[90:91], 17, v2
    v_cmp_lt_i32 s[92:93], 18, v2
    v_cmp_lt_i32 s[94:95], 19, v2
    v_cndmask_b32 v48, v3, v48, s[80:81]
    v_cndmask_b32 v49, v3, v49, s[82:83]
    v_cndmask_b32 v50, v3, v50, s[84:85]
    v_cndmask_b32 v51, v3, v51, s[86:87]
    v_cndmask_b32 v52, v3, v52, s[88:89]
    v_cndmask_b32 v53, v3, v53, s[90:91]
    v_cndmask_b32 v54, v3, v54, s[92:93]
    v_cndmask_b32 v55, v3, v55, s[94:95]
    s_branch L_k_exp
L_k_slow:
    s_cmp_lg_u32 s101, 0
    s_cbranch_scc1 L_k_done
    s_mov_b32 s101, 1
    v_max3_f32 v2, v48, v49, v50
    v_max3_f32 v3, v51, v52, v53
    v_max3_f32 v2, v2, v54, v55
    v_max_f32 v2, v2, v3
    v_mov_b32 v3, v2
    s_nop 1
    v_permlane32_swap_b32 v2, v3
    s_nop 0
    v_max_f32 v2, v2, v3
    v_mov_b32 v3, v2
    s_nop 1
    v_permlane16_swap_b32 v2, v3
    s_nop 0
    v_max_f32 v2, v2, v3
    v_mul_f32 v2, s62, v2
    v_max_f32 v26, v24, v2
    v_sub_f32 v27, v24, v26
    v_exp_f32 v27, v27
    v_mov_b32 v24, v26
    s_cmp_lg_u32 s44, 0
    s_mov_b32 s44, 0
    v_mul_f32 v25, v25, v27
    s_cbranch_scc1 L_k_exp
    s_lshl_b32 s32, s2, 6
    s_add_u32 s32, s32, s42
    s_lshl1_add_u32 s32, s32, s48
    s_lshl_b32 s32, s32, 6
    s_add_u32 s32, s32, 262144
    v_and_b32 v3, 15, v1
    v_lshl_add_u32 v3, v3, 2, s32
    global_store_dword v3, v27, s[18:19]
    s_sub_u32 s32, s42, 1
    s_bitset1_b64 s[26:27], s32
    s_branch L_k_exp
L_k_noplan:
    s_mov_b32 s59, 1
    v_mov_b32 v3, 160640
L_k_plan:
    ds_read_b128 v[4:7], v3
    s_waitcnt lgkmcnt(0)
    v_readfirstlane_b32 s32, v7
    v_readfirstlane_b32 s46, v4
    v_readfirstlane_b32 s47, v5
    v_readfirstlane_b32 s23, v6
    s_cmp_lg_u32 s32, 0
    s_cbranch_scc1 L_k_got
    s_sleep 1
    s_sub_u32 s38, s38, 1
    s_cbranch_scc0 L_k_plan
    s_endpgm
L_k_got:
    s_lshr_b32 s56, s32, 8
    s_add_u32 s56, s56, 1
    s_and_b32 s52, s23, 1
    s_lshr_b32 s23, s23, 8
    s_min_u32 s22, s23, 50
    s_bfm_b64 s[24:25], s41, 0
    s_or_b64 s[24:25], s[24:25], s[46:47]
    s_and_b32 s47, s47, 0x3ffff
    s_branch L_k_first
L_v_more:
    s_mov_b32 s21, s22
    s_mov_b32 s22, s23
    s_mov_b32 s20, s21
    s_mov_b32 s24, 0
    s_andn2_b32 s25, s25, 0x3ffff
    s_mov_b64 s[46:47], s[24:25]
    s_branch L_k_first
L_k_empty:
    s_cmp_eq_u32 s59, 0
    s_cbranch_scc1 L_k_noplan
    v_mov_b32 v2, v25
    v_mov_b32 v3, v25
    s_nop 1
    v_permlane32_swap_b32 v2, v3
    s_nop 0
    v_add_f32 v2, v2, v3
    v_mov_b32 v3, v2
    s_nop 1
    v_permlane16_swap_b32 v2, v3
    s_nop 0
    v_add_f32 v2, v2, v3
    v_rcp_f32 v22, v2
    s_mov_b32 s20, s22
    s_mov_b32 s46, s24
    s_and_b32 s47, s25, 0x3ffff
    s_cmp_eq_u32 s21, 0
    s_cselect_b32 s47, s47, s25
    s_ff1_i32_b64 s96, s[46:47]
    s_bitset0_b64 s[46:47], s96
    s_add_u32 s33, s96, s20
    s_mul_i32 s32, s33, 43
    s_lshr_b32 s32, s32, 8
    s_mul_i32 s32, s32, 6
    s_sub_u32 s32, s33, s32
    s_lshl_b32 s60, s32, 13
    s_lshl3_add_u32 s98, s32, s99
    s_and_b32 s32, s96, 0x40000000
    s_add_u32 s97, s33, 1
    s_or_b32 s97, s97, s32
    s_sub_u32 s43, s96, s21
    s_lshl_b32 s43, s43, 11
    v_add_u32 v16, s60, v12
    v_add_u32 v17, s60, v13
    v_add_u32 v18, s60, v14
    v_add_u32 v19, s60, v15
    ds_read_b64 v[30:31], v28
    s_cmp_lt_i32 s96, 0
    s_cbranch_scc1 L_v_empty
L_v_next:
    v_mov_b32 v29, s98
    v_mov_b32 v62, s97
    v_add_u32 v21, s43, v20
    s_add_u32 s42, s96, 1
    s_cmp_eq_u64 s[46:47], 0
    s_cbranch_scc1 L_v_islast
L_v_next2:
    ds_read_b128 v[160:163], v21
    s_waitcnt lgkmcnt(1)
    v_readfirstlane_b32 s49, v30
    s_cmp_ge_i32 s49, s97
    s_cbranch_scc1 L_v_rd
L_v_poll:
    ds_read_b64 v[30:31], v28
    s_sub_u32 s38, s38, 1
    s_cbranch_scc1 L_end
    s_waitcnt lgkmcnt(0)
    v_readfirstlane_b32 s49, v30
    s_cmp_ge_i32 s49, s97
    s_cbranch_scc0 L_v_poll
L_v_rd:
    ds_read_b64_tr_b16 v[96:97], v16 offset:0
    ds_read_b64_tr_b16 v[98:99], v16 offset:4096
    ds_read_b64_tr_b16 v[100:101], v16 offset:8
    ds_read_b64_tr_b16 v[102:103], v16 offset:4104
    ds_read_b64_tr_b16 v[104:105], v17 offset:0
    ds_read_b64_tr_b16 v[106:107], v17 offset:4096
    ds_read_b64_tr_b16 v[108:109], v17 offset:8
    ds_read_b64_tr_b16 v[110:111], v17 offset:4104
    ds_read_b64_tr_b16 v[112:113], v18 offset:0
    ds_read_b64_tr_b16 v[114:115], v18 offset:4096
    ds_read_b64_tr_b16 v[116:117], v18 offset:8
    ds_read_b64_tr_b16 v[118:119], v18 offset:4104
    ds_read_b64_tr_b16 v[120:121], v19 offset:0
    ds_read_b64_tr_b16 v[122:123], v19 offset:4096
    ds_read_b64_tr_b16 v[124:125], v19 offset:8
    ds_read_b64_tr_b16 v[126:127], v19 offset:4104
    v_readfirstlane_b32 s50, v31
    s_cmp_gt_i32 s49, s97
    s_cselect_b32 s32, 1, s26
    s_or_b32 s32, s32, s27
    s_and_b32 s33, s50, s52
    s_or_b32 s32, s32, s33
    s_cbranch_scc0 L_v_lat
.p2align 3
L_v_top:
    s_ff1_i32_b64 s96, s[46:47]
    s_bitset0_b64 s[46:47], s96
    s_add_u32 s33, s96, s20
    s_mul_i32 s32, s33, 43
    s_lshr_b32 s32, s32, 8
    s_mul_i32 s32, s32, 6
    s_sub_u32 s32, s33, s32
    s_lshl_b32 s60, s32, 13
    s_lshl3_add_u32 s98, s32, s99
    s_and_b32 s32, s96, 0x40000000
    s_add_u32 s97, s33, 1
    s_or_b32 s97, s97, s32
    s_sub_u32 s43, s96, s21
    s_lshl_b32 s43, s43, 11
    v_add_u32 v16, s60, v12
    v_add_u32 v17, s60, v13
    v_add_u32 v18, s60, v14
    v_add_u32 v19, s60, v15
    s_sub_u32 s32, s42, 1
    s_bitcmp1_b64 s[26:27], s32
    s_cbranch_scc1 L_v_resc
L_v_top2:
    s_waitcnt lgkmcnt(14)
    v_readfirstlane_b32 s50, v31
    v_readfirstlane_b32 s49, v30
    v_mov_b64 v[56:57], v[160:161]
    v_mov_b64 v[58:59], v[162:163]
    s_and_b32 s32, s50, s52
    s_cbranch_scc1 L_v_merge
L_v_top3:
    s_cmp_ge_i32 s49, s97
    s_cbranch_scc0 L_v_pv
    v_add_u32 v21, s43, v20
    s_waitcnt lgkmcnt(0)
    ds_write_b32 v29, v62
    ds_read_b64 v[30:31], v28
    ds_read_b128 v[160:163], v21
    v_mfma_f32_16x16x32_bf16 v[128:131], v[96:99], v[56:59], v[128:131]
    ds_read_b64_tr_b16 v[96:97], v16 offset:0
    ds_read_b64_tr_b16 v[98:99], v16 offset:4096
    v_mfma_f32_16x16x32_bf16 v[132:135], v[100:103], v[56:59], v[132:135]
    ds_read_b64_tr_b16 v[100:101], v16 offset:8
    ds_read_b64_tr_b16 v[102:103], v16 offset:4104
    v_mfma_f32_16x16x32_bf16 v[136:139], v[104:107], v[56:59], v[136:139]
    ds_read_b64_tr_b16 v[104:105], v17 offset:0
    ds_read_b64_tr_b16 v[106:107], v17 offset:4096
    v_mfma_f32_16x16x32_bf16 v[140:143], v[108:111], v[56:59], v[140:143]
    ds_read_b64_tr_b16 v[108:109], v17 offset:8
    ds_read_b64_tr_b16 v[110:111], v17 offset:4104
    v_mfma_f32_16x16x32_bf16 v[144:147], v[112:115], v[56:59], v[144:147]
    ds_read_b64_tr_b16 v[112:113], v18 offset:0
    ds_read_b64_tr_b16 v[114:115], v18 offset:4096
    v_mfma_f32_16x16x32_bf16 v[148:151], v[116:119], v[56:59], v[148:151]
    ds_read_b64_tr_b16 v[116:117], v18 offset:8
    ds_read_b64_tr_b16 v[118:119], v18 offset:4104
    v_mfma_f32_16x16x32_bf16 v[152:155], v[120:123], v[56:59], v[152:155]
    ds_read_b64_tr_b16 v[120:121], v19 offset:0
    ds_read_b64_tr_b16 v[122:123], v19 offset:4096
    v_mfma_f32_16x16x32_bf16 v[156:159], v[124:127], v[56:59], v[156:159]
    ds_read_b64_tr_b16 v[124:125], v19 offset:8
    ds_read_b64_tr_b16 v[126:127], v19 offset:4104
    v_mov_b32 v29, s98
    v_mov_b32 v62, s97
    s_add_u32 s42, s96, 1
    s_branch L_v_top
L_v_lat:
    s_waitcnt lgkmcnt(14)
    v_mov_b64 v[56:57], v[160:161]
    v_mov_b64 v[58:59], v[162:163]
    s_ff1_i32_b64 s96, s[46:47]
    s_bitset0_b64 s[46:47], s96
    v_mfma_f32_16x16x32_bf16 v[128:131], v[96:99], v[56:59], v[128:131]
    s_add_u32 s33, s96, s20
    s_mul_i32 s32, s33, 43
    s_waitcnt lgkmcnt(12)
    v_mfma_f32_16x16x32_bf16 v[132:135], v[100:103], v[56:59], v[132:135]
    s_lshr_b32 s32, s32, 8
    s_mul_i32 s32, s32, 6
    s_waitcnt lgkmcnt(10)
    v_mfma_f32_16x16x32_bf16 v[136:139], v[104:107], v[56:59], v[136:139]
    s_sub_u32 s32, s33, s32
    s_lshl_b32 s60, s32, 13
    s_waitcnt lgkmcnt(8)
    v_mfma_f32_16x16x32_bf16 v[140:143], v[108:111], v[56:59], v[140:143]
    s_lshl3_add_u32 s98, s32, s99
    s_and_b32 s32, s96, 0x40000000
    s_waitcnt lgkmcnt(6)
    v_mfma_f32_16x16x32_bf16 v[144:147], v[112:115], v[56:59], v[144:147]
    s_add_u32 s97, s33, 1
    s_or_b32 s97, s97, s32
    s_waitcnt lgkmcnt(4)
    v_mfma_f32_16x16x32_bf16 v[148:151], v[116:119], v[56:59], v[148:151]
    s_sub_u32 s43, s96, s21
    s_lshl_b32 s43, s43, 11
    s_waitcnt lgkmcnt(2)
    v_mfma_f32_16x16x32_bf16 v[152:155], v[120:123], v[56:59], v[152:155]
    v_add_u32 v16, s60, v12
    v_add_u32 v17, s60, v13
    s_waitcnt lgkmcnt(0)
    ds_write_b32 v29, v62
    ds_read_b64 v[30:31], v28
    v_mfma_f32_16x16x32_bf16 v[156:159], v[124:127], v[56:59], v[156:159]
    v_add_u32 v18, s60, v14
    v_add_u32 v19, s60, v15
    s_cmp_ge_i32 s96, 0
    s_cbranch_scc1 L_v_next
    s_branch L_v_empty
L_v_pv:
    s_cmp_lt_i32 s96, 0
    s_cbranch_scc1 L_v_islast2
L_v_pv2:
    v_mfma_f32_16x16x32_bf16 v[128:131], v[96:99], v[56:59], v[128:131]
    s_waitcnt lgkmcnt(12)
    v_mfma_f32_16x16x32_bf16 v[132:135], v[100:103], v[56:59], v[132:135]
    s_waitcnt lgkmcnt(10)
    v_mfma_f32_16x16x32_bf16 v[136:139], v[104:107], v[56:59], v[136:139]
    s_waitcnt lgkmcnt(8)
    v_mfma_f32_16x16x32_bf16 v[140:143], v[108:111], v[56:59], v[140:143]
    s_waitcnt lgkmcnt(6)
    v_mfma_f32_16x16x32_bf16 v[144:147], v[112:115], v[56:59], v[144:147]
    s_waitcnt lgkmcnt(4)
    v_mfma_f32_16x16x32_bf16 v[148:151], v[116:119], v[56:59], v[148:151]
    s_waitcnt lgkmcnt(2)
    v_mfma_f32_16x16x32_bf16 v[152:155], v[120:123], v[56:59], v[152:155]
    s_waitcnt lgkmcnt(0)
    ds_write_b32 v29, v62
    ds_read_b64 v[30:31], v28
    v_mfma_f32_16x16x32_bf16 v[156:159], v[124:127], v[56:59], v[156:159]
    s_cmp_ge_i32 s96, 0
    s_cbranch_scc1 L_v_next
L_v_empty:
    s_cmp_lt_u32 s22, s23
    s_cbranch_scc1 L_v_more
    s_cmp_lg_u32 s52, 0
    s_cbranch_scc1 L_c_mwait0
L_c_store:
    v_mov_b32 v2, v25
    v_and_b32 v4, 15, v1
    v_lshl_add_u32 v4, v4, 8, s58
    v_permlane32_swap_b32 v25, v2
    s_nop 0
    v_add_f32 v25, v25, v2
    v_mov_b32 v2, v25
    v_lshl_add_u32 v4, v60, 4, v4
    s_nop 0
    v_permlane16_swap_b32 v25, v2
    s_nop 0
    v_add_f32 v25, v25, v2
    v_rcp_f32 v26, v25
    s_cmp_lg_u32 s57, 0
    v_pk_mul_f32 v[128:129], v[128:129], v[26:27] op_sel_hi:[1,0]
    v_pk_mul_f32 v[130:131], v[130:131], v[26:27] op_sel_hi:[1,0]
    v_pk_mul_f32 v[132:133], v[132:133], v[26:27] op_sel_hi:[1,0]
    v_pk_mul_f32 v[134:135], v[134:135], v[26:27] op_sel_hi:[1,0]
    v_pk_mul_f32 v[136:137], v[136:137], v[26:27] op_sel_hi:[1,0]
    v_pk_mul_f32 v[138:139], v[138:139], v[26:27] op_sel_hi:[1,0]
    v_pk_mul_f32 v[140:141], v[140:141], v[26:27] op_sel_hi:[1,0]
    v_pk_mul_f32 v[142:143], v[142:143], v[26:27] op_sel_hi:[1,0]
    v_pk_mul_f32 v[144:145], v[144:145], v[26:27] op_sel_hi:[1,0]
    v_pk_mul_f32 v[146:147], v[146:147], v[26:27] op_sel_hi:[1,0]
    v_pk_mul_f32 v[148:149], v[148:149], v[26:27] op_sel_hi:[1,0]
    v_pk_mul_f32 v[150:151], v[150:151], v[26:27] op_sel_hi:[1,0]
    v_pk_mul_f32 v[152:153], v[152:153], v[26:27] op_sel_hi:[1,0]
    v_pk_mul_f32 v[154:155], v[154:155], v[26:27] op_sel_hi:[1,0]
    v_pk_mul_f32 v[156:157], v[156:157], v[26:27] op_sel_hi:[1,0]
    v_pk_mul_f32 v[158:159], v[158:159], v[26:27] op_sel_hi:[1,0]
    v_cvt_pk_bf16_f32 v64, v128, v129
    v_cvt_pk_bf16_f32 v65, v130, v131
    v_cvt_pk_bf16_f32 v66, v132, v133
    v_cvt_pk_bf16_f32 v67, v134, v135
    v_cvt_pk_bf16_f32 v68, v136, v137
    v_cvt_pk_bf16_f32 v69, v138, v139
    v_cvt_pk_bf16_f32 v70, v140, v141
    v_cvt_pk_bf16_f32 v71, v142, v143
    v_cvt_pk_bf16_f32 v72, v144, v145
    v_cvt_pk_bf16_f32 v73, v146, v147
    v_cvt_pk_bf16_f32 v74, v148, v149
    v_cvt_pk_bf16_f32 v75, v150, v151
    v_cvt_pk_bf16_f32 v76, v152, v153
    v_cvt_pk_bf16_f32 v77, v154, v155
    v_cvt_pk_bf16_f32 v78, v156, v157
    v_cvt_pk_bf16_f32 v79, v158, v159
    s_cbranch_scc1 L_publish
    global_store_dwordx4 v4, v[64:67], s[14:15] offset:0
    global_store_dwordx4 v4, v[68:71], s[14:15] offset:64
    global_store_dwordx4 v4, v[72:75], s[14:15] offset:128
    global_store_dwordx4 v4, v[76:79], s[14:15] offset:192
    s_endpgm
L_v_islast2:
    s_sub_u32 s32, s23, s22
    s_or_b32 s32, s32, s52
    s_or_b32 s32, s32, s57
    s_cbranch_scc1 L_v_pv2
    s_branch L_v_lpv
L_v_islast:
    s_sub_u32 s32, s23, s22
    s_or_b32 s32, s32, s52
    s_or_b32 s32, s32, s57
    s_or_b32 s32, s32, s26
    s_or_b32 s32, s32, s27
    s_cbranch_scc1 L_v_next2
    ds_read_b128 v[56:59], v21
    s_waitcnt lgkmcnt(1)
    v_readfirstlane_b32 s49, v30
    s_cmp_ge_i32 s49, s97
    s_cbranch_scc1 L_v_lrd
L_v_lpoll:
    ds_read_b64 v[30:31], v28
    s_sub_u32 s38, s38, 1
    s_cbranch_scc1 L_end
    s_waitcnt lgkmcnt(0)
    v_readfirstlane_b32 s49, v30
    s_cmp_ge_i32 s49, s97
    s_cbranch_scc0 L_v_lpoll
L_v_lrd:
    ds_read_b64_tr_b16 v[96:97], v16 offset:0
    ds_read_b64_tr_b16 v[98:99], v16 offset:4096
    ds_read_b64_tr_b16 v[100:101], v16 offset:8
    ds_read_b64_tr_b16 v[102:103], v16 offset:4104
    ds_read_b64_tr_b16 v[104:105], v17 offset:0
    ds_read_b64_tr_b16 v[106:107], v17 offset:4096
    ds_read_b64_tr_b16 v[108:109], v17 offset:8
    ds_read_b64_tr_b16 v[110:111], v17 offset:4104
    ds_read_b64_tr_b16 v[112:113], v18 offset:0
    ds_read_b64_tr_b16 v[114:115], v18 offset:4096
    ds_read_b64_tr_b16 v[116:117], v18 offset:8
    ds_read_b64_tr_b16 v[118:119], v18 offset:4104
    ds_read_b64_tr_b16 v[120:121], v19 offset:0
    ds_read_b64_tr_b16 v[122:123], v19 offset:4096
    ds_read_b64_tr_b16 v[124:125], v19 offset:8
    ds_read_b64_tr_b16 v[126:127], v19 offset:4104
L_v_lpv:
    s_waitcnt lgkmcnt(14)
    v_mfma_f32_16x16x32_bf16 v[128:131], v[96:99], v[56:59], v[128:131]
    s_waitcnt lgkmcnt(12)
    v_mfma_f32_16x16x32_bf16 v[132:135], v[100:103], v[56:59], v[132:135]
    s_waitcnt lgkmcnt(10)
    v_mfma_f32_16x16x32_bf16 v[136:139], v[104:107], v[56:59], v[136:139]
    s_waitcnt lgkmcnt(8)
    v_mfma_f32_16x16x32_bf16 v[140:143], v[108:111], v[56:59], v[140:143]
    s_waitcnt lgkmcnt(6)
    v_mfma_f32_16x16x32_bf16 v[144:147], v[112:115], v[56:59], v[144:147]
    s_waitcnt lgkmcnt(4)
    v_mfma_f32_16x16x32_bf16 v[148:151], v[116:119], v[56:59], v[148:151]
    v_pk_mul_f32 v[128:129], v[128:129], v[22:23] op_sel_hi:[1,0]
    v_pk_mul_f32 v[130:131], v[130:131], v[22:23] op_sel_hi:[1,0]
    s_waitcnt lgkmcnt(2)
    v_mfma_f32_16x16x32_bf16 v[152:155], v[120:123], v[56:59], v[152:155]
    v_pk_mul_f32 v[132:133], v[132:133], v[22:23] op_sel_hi:[1,0]
    v_pk_mul_f32 v[134:135], v[134:135], v[22:23] op_sel_hi:[1,0]
    s_waitcnt lgkmcnt(0)
    v_mfma_f32_16x16x32_bf16 v[156:159], v[124:127], v[56:59], v[156:159]
    v_cvt_pk_bf16_f32 v64, v128, v129
    v_cvt_pk_bf16_f32 v65, v130, v131
    v_cvt_pk_bf16_f32 v66, v132, v133
    v_cvt_pk_bf16_f32 v67, v134, v135
    global_store_dwordx4 v23, v[64:67], s[14:15] offset:0
    v_pk_mul_f32 v[136:137], v[136:137], v[22:23] op_sel_hi:[1,0]
    v_pk_mul_f32 v[138:139], v[138:139], v[22:23] op_sel_hi:[1,0]
    v_pk_mul_f32 v[140:141], v[140:141], v[22:23] op_sel_hi:[1,0]
    v_pk_mul_f32 v[142:143], v[142:143], v[22:23] op_sel_hi:[1,0]
    v_cvt_pk_bf16_f32 v68, v136, v137
    v_cvt_pk_bf16_f32 v69, v138, v139
    v_cvt_pk_bf16_f32 v70, v140, v141
    v_cvt_pk_bf16_f32 v71, v142, v143
    global_store_dwordx4 v23, v[68:71], s[14:15] offset:64
    v_pk_mul_f32 v[144:145], v[144:145], v[22:23] op_sel_hi:[1,0]
    v_pk_mul_f32 v[146:147], v[146:147], v[22:23] op_sel_hi:[1,0]
    v_pk_mul_f32 v[148:149], v[148:149], v[22:23] op_sel_hi:[1,0]
    v_pk_mul_f32 v[150:151], v[150:151], v[22:23] op_sel_hi:[1,0]
    v_cvt_pk_bf16_f32 v72, v144, v145
    v_cvt_pk_bf16_f32 v73, v146, v147
    v_cvt_pk_bf16_f32 v74, v148, v149
    v_cvt_pk_bf16_f32 v75, v150, v151
    global_store_dwordx4 v23, v[72:75], s[14:15] offset:128
    v_pk_mul_f32 v[152:153], v[152:153], v[22:23] op_sel_hi:[1,0]
    v_pk_mul_f32 v[154:155], v[154:155], v[22:23] op_sel_hi:[1,0]
    v_pk_mul_f32 v[156:157], v[156:157], v[22:23] op_sel_hi:[1,0]
    v_pk_mul_f32 v[158:159], v[158:159], v[22:23] op_sel_hi:[1,0]
    v_cvt_pk_bf16_f32 v76, v152, v153
    v_cvt_pk_bf16_f32 v77, v154, v155
    v_cvt_pk_bf16_f32 v78, v156, v157
    v_cvt_pk_bf16_f32 v79, v158, v159
    global_store_dwordx4 v23, v[76:79], s[14:15] offset:192
    ds_write_b32 v29, v62
    s_endpgm
L_v_resc:
    s_bitset0_b64 s[26:27], s32
    s_lshl_b32 s32, s2, 6
    s_add_u32 s32, s32, s42
    s_lshl1_add_u32 s32, s32, s48
    s_lshl_b32 s32, s32, 6
    s_add_u32 s32, s32, 262144
    v_and_b32 v3, 15, v1
    v_lshl_add_u32 v3, v3, 2, s32
    s_waitcnt vmcnt(0)
    global_load_dword v27, v3, s[18:19] sc1
    s_waitcnt vmcnt(0)
    v_pk_mul_f32 v[128:129], v[128:129], v[26:27] op_sel:[0,1] op_sel_hi:[1,1]
    v_pk_mul_f32 v[130:131], v[130:131], v[26:27] op_sel:[0,1] op_sel_hi:[1,1]
    v_pk_mul_f32 v[132:133], v[132:133], v[26:27] op_sel:[0,1] op_sel_hi:[1,1]
    v_pk_mul_f32 v[134:135], v[134:135], v[26:27] op_sel:[0,1] op_sel_hi:[1,1]
    v_pk_mul_f32 v[136:137], v[136:137], v[26:27] op_sel:[0,1] op_sel_hi:[1,1]
    v_pk_mul_f32 v[138:139], v[138:139], v[26:27] op_sel:[0,1] op_sel_hi:[1,1]
    v_pk_mul_f32 v[140:141], v[140:141], v[26:27] op_sel:[0,1] op_sel_hi:[1,1]
    v_pk_mul_f32 v[142:143], v[142:143], v[26:27] op_sel:[0,1] op_sel_hi:[1,1]
    v_pk_mul_f32 v[144:145], v[144:145], v[26:27] op_sel:[0,1] op_sel_hi:[1,1]
    v_pk_mul_f32 v[146:147], v[146:147], v[26:27] op_sel:[0,1] op_sel_hi:[1,1]
    v_pk_mul_f32 v[148:149], v[148:149], v[26:27] op_sel:[0,1] op_sel_hi:[1,1]
    v_pk_mul_f32 v[150:151], v[150:151], v[26:27] op_sel:[0,1] op_sel_hi:[1,1]
    v_pk_mul_f32 v[152:153], v[152:153], v[26:27] op_sel:[0,1] op_sel_hi:[1,1]
    v_pk_mul_f32 v[154:155], v[154:155], v[26:27] op_sel:[0,1] op_sel_hi:[1,1]
    v_pk_mul_f32 v[156:157], v[156:157], v[26:27] op_sel:[0,1] op_sel_hi:[1,1]
    v_pk_mul_f32 v[158:159], v[158:159], v[26:27] op_sel:[0,1] op_sel_hi:[1,1]
    s_branch L_v_top2
L_v_merge:
    s_cmp_eq_u64 s[26:27], 0
    s_cbranch_scc0 L_v_top3
L_c_merge:
    s_mul_i32 s32, s48, 4224
    s_add_u32 s32, s32, 151552
    v_and_b32 v3, 15, v1
    v_lshl_add_u32 v2, v1, 4, s32
    v_lshl_add_u32 v3, v3, 3, s32
    s_waitcnt lgkmcnt(0)
    ds_write_b32 v29, v62
    ds_read_b64 v[6:7], v3 offset:4096
    ds_read_b128 v[64:67], v2 offset:0
    ds_read_b128 v[68:71], v2 offset:1024
    ds_read_b128 v[72:75], v2 offset:2048
    ds_read_b128 v[76:79], v2 offset:3072
    s_cmp_eq_u32 s59, 2
    s_waitcnt lgkmcnt(0)
    s_cbranch_scc1 L_c_mfin
    v_sub_f32 v6, v6, v24
    v_cmp_nge_f32 vcc, 0x41800000, v6
    s_mov_b32 s52, 2
    s_nop 3
    s_cbranch_vccnz L_v_top3
    s_branch L_c_madd
L_c_mfin:
    v_max_f32 v26, v24, v6
    v_sub_f32 v27, v24, v26
    v_sub_f32 v6, v6, v26
    v_exp_f32 v27, v27
    s_nop 0
    v_mul_f32 v25, v25, v27
    v_pk_mul_f32 v[128:129], v[128:129], v[26:27] op_sel:[0,1] op_sel_hi:[1,1]
    v_pk_mul_f32 v[130:131], v[130:131], v[26:27] op_sel:[0,1] op_sel_hi:[1,1]
    v_pk_mul_f32 v[132:133], v[132:133], v[26:27] op_sel:[0,1] op_sel_hi:[1,1]
    v_pk_mul_f32 v[134:135], v[134:135], v[26:27] op_sel:[0,1] op_sel_hi:[1,1]
    v_pk_mul_f32 v[136:137], v[136:137], v[26:27] op_sel:[0,1] op_sel_hi:[1,1]
    v_pk_mul_f32 v[138:139], v[138:139], v[26:27] op_sel:[0,1] op_sel_hi:[1,1]
    v_pk_mul_f32 v[140:141], v[140:141], v[26:27] op_sel:[0,1] op_sel_hi:[1,1]
    v_pk_mul_f32 v[142:143], v[142:143], v[26:27] op_sel:[0,1] op_sel_hi:[1,1]
    v_pk_mul_f32 v[144:145], v[144:145], v[26:27] op_sel:[0,1] op_sel_hi:[1,1]
    v_pk_mul_f32 v[146:147], v[146:147], v[26:27] op_sel:[0,1] op_sel_hi:[1,1]
    v_pk_mul_f32 v[148:149], v[148:149], v[26:27] op_sel:[0,1] op_sel_hi:[1,1]
    v_pk_mul_f32 v[150:151], v[150:151], v[26:27] op_sel:[0,1] op_sel_hi:[1,1]
    v_pk_mul_f32 v[152:153], v[152:153], v[26:27] op_sel:[0,1] op_sel_hi:[1,1]
    v_pk_mul_f32 v[154:155], v[154:155], v[26:27] op_sel:[0,1] op_sel_hi:[1,1]
    v_pk_mul_f32 v[156:157], v[156:157], v[26:27] op_sel:[0,1] op_sel_hi:[1,1]
    v_pk_mul_f32 v[158:159], v[158:159], v[26:27] op_sel:[0,1] op_sel_hi:[1,1]
L_c_madd:
    v_exp_f32 v6, v6
    s_mov_b32 s52, 0
    v_mul_f32 v6, v6, v7
    v_fmac_f32 v25, 0x3e800000, v6
    v_lshlrev_b32 v80, 16, v64
    v_and_b32 v81, 0xffff0000, v64
    v_pk_fma_f32 v[128:129], v[80:81], v[6:7], v[128:129] op_sel_hi:[1,0,1]
    v_lshlrev_b32 v82, 16, v65
    v_and_b32 v83, 0xffff0000, v65
    v_pk_fma_f32 v[130:131], v[82:83], v[6:7], v[130:131] op_sel_hi:[1,0,1]
    v_lshlrev_b32 v84, 16, v66
    v_and_b32 v85, 0xffff0000, v66
    v_pk_fma_f32 v[132:133], v[84:85], v[6:7], v[132:133] op_sel_hi:[1,0,1]
    v_lshlrev_b32 v86, 16, v67
    v_and_b32 v87, 0xffff0000, v67
    v_pk_fma_f32 v[134:135], v[86:87], v[6:7], v[134:135] op_sel_hi:[1,0,1]
    v_lshlrev_b32 v80, 16, v68
    v_and_b32 v81, 0xffff0000, v68
    v_pk_fma_f32 v[136:137], v[80:81], v[6:7], v[136:137] op_sel_hi:[1,0,1]
    v_lshlrev_b32 v82, 16, v69
    v_and_b32 v83, 0xffff0000, v69
    v_pk_fma_f32 v[138:139], v[82:83], v[6:7], v[138:139] op_sel_hi:[1,0,1]
    v_lshlrev_b32 v84, 16, v70
    v_and_b32 v85, 0xffff0000, v70
    v_pk_fma_f32 v[140:141], v[84:85], v[6:7], v[140:141] op_sel_hi:[1,0,1]
    v_lshlrev_b32 v86, 16, v71
    v_and_b32 v87, 0xffff0000, v71
    v_pk_fma_f32 v[142:143], v[86:87], v[6:7], v[142:143] op_sel_hi:[1,0,1]
    v_lshlrev_b32 v80, 16, v72
    v_and_b32 v81, 0xffff0000, v72
    v_pk_fma_f32 v[144:145], v[80:81], v[6:7], v[144:145] op_sel_hi:[1,0,1]
    v_lshlrev_b32 v82, 16, v73
    v_and_b32 v83, 0xffff0000, v73
    v_pk_fma_f32 v[146:147], v[82:83], v[6:7], v[146:147] op_sel_hi:[1,0,1]
    v_lshlrev_b32 v84, 16, v74
    v_and_b32 v85, 0xffff0000, v74
    v_pk_fma_f32 v[148:149], v[84:85], v[6:7], v[148:149] op_sel_hi:[1,0,1]
    v_lshlrev_b32 v86, 16, v75
    v_and_b32 v87, 0xffff0000, v75
    v_pk_fma_f32 v[150:151], v[86:87], v[6:7], v[150:151] op_sel_hi:[1,0,1]
    v_lshlrev_b32 v80, 16, v76
    v_and_b32 v81, 0xffff0000, v76
    v_pk_fma_f32 v[152:153], v[80:81], v[6:7], v[152:153] op_sel_hi:[1,0,1]
    v_lshlrev_b32 v82, 16, v77
    v_and_b32 v83, 0xffff0000, v77
    v_pk_fma_f32 v[154:155], v[82:83], v[6:7], v[154:155] op_sel_hi:[1,0,1]
    v_lshlrev_b32 v84, 16, v78
    v_and_b32 v85, 0xffff0000, v78
    v_pk_fma_f32 v[156:157], v[84:85], v[6:7], v[156:157] op_sel_hi:[1,0,1]
    v_lshlrev_b32 v86, 16, v79
    v_and_b32 v87, 0xffff0000, v79
    v_pk_fma_f32 v[158:159], v[86:87], v[6:7], v[158:159] op_sel_hi:[1,0,1]
    s_cmp_eq_u32 s59, 2
    s_cbranch_scc1 L_c_store
    v_mov_b32 v2, v25
    v_mov_b32 v3, v25
    s_nop 1
    v_permlane32_swap_b32 v2, v3
    s_nop 0
    v_add_f32 v2, v2, v3
    v_mov_b32 v3, v2
    s_nop 1
    v_permlane16_swap_b32 v2, v3
    s_nop 0
    v_add_f32 v2, v2, v3
    v_rcp_f32 v22, v2
    s_branch L_v_top3
L_c_mwait0:
    s_mov_b32 s59, 2
L_c_mwait:
    ds_read_b64 v[30:31], v28
    s_waitcnt lgkmcnt(0)
    v_readfirstlane_b32 s50, v31
    s_cmp_lg_u32 s50, 0
    s_cbranch_scc1 L_c_merge
    s_sleep 1
    s_sub_u32 s38, s38, 1
    s_cbranch_scc0 L_c_mwait
    s_endpgm
L_publish:
    v_lshl_add_u32 v4, v1, 4, s58
    s_lshl_b32 s34, s81, 2
    v_mov_b32 v5, s34
    v_lshlrev_b32 v6, 1, v5
    v_add_u32 v6, 160068, v6
    ds_read_b32 v6, v6
    s_lshl3_add_u32 s32, s81, s29
    s_lshl_b32 s32, s32, 9
    s_lshl2_add_u32 s33, s48, s32
    v_mov_b32 v7, s33
    s_lshl_b32 s33, s48, 7
    s_add_u32 s32, s32, s33
    v_lshl_add_u32 v3, v1, 3, s32
    s_getreg_b32 s34, hwreg(HW_REG_XCC_ID, 0, 4)
    s_lshl_b32 s34, s34, 4
    s_or_b32 s34, s34, s29
    s_or_b32 s34, s34, 0x100
    s_waitcnt lgkmcnt(0)
    v_readfirstlane_b32 s33, v6
    s_lshr_b32 s33, s33, 16
    s_cmp_eq_u32 s33, s34
    s_cbranch_scc1 L_pub_fast
    global_load_dword v6, v5, s[16:17] offset:128 sc1
    s_waitcnt vmcnt(0)
    v_readfirstlane_b32 s33, v6
    s_lshr_b32 s33, s33, 16
    s_cmp_eq_u32 s33, s34
    s_cbranch_scc0 L_pub_slow
L_pub_fast:
    global_store_dwordx4 v4, v[64:67], s[14:15] offset:0
    global_store_dwordx4 v4, v[68:71], s[14:15] offset:1024
    global_store_dwordx4 v4, v[72:75], s[14:15] offset:2048
    global_store_dwordx4 v4, v[76:79], s[14:15] offset:3072
    s_mov_b64 exec, 0xffff
    global_store_dwordx2 v3, v[24:25], s[18:19]
    v_mov_b32 v6, 1
    s_waitcnt vmcnt(0)
    s_mov_b64 exec, 1
    global_store_dword v7, v6, s[18:19] offset:256
    s_endpgm
L_pub_slow:
    global_store_dwordx4 v4, v[64:67], s[14:15] offset:0 sc1
    global_store_dwordx4 v4, v[68:71], s[14:15] offset:1024 sc1
    global_store_dwordx4 v4, v[72:75], s[14:15] offset:2048 sc1
    global_store_dwordx4 v4, v[76:79], s[14:15] offset:3072 sc1
    s_mov_b64 exec, 0xffff
    global_store_dwordx2 v3, v[24:25], s[18:19] sc1
    s_lshl1_add_u32 s33, s29, s48
    s_lshl_b32 s33, 1, s33
    v_mov_b32 v6, s33
    s_waitcnt vmcnt(0)
    s_mov_b64 exec, 1
    global_atomic_add v5, v6, s[16:17]
    s_endpgm
L_ctl0:
    s_barrier
    s_branch L_ctl
L_planner:
    s_cmp_eq_u32 s30, 5
    s_cbranch_scc1 L_ctl0
    s_sub_u32 s48, s30, 3
    s_lshl_b32 s60, s48, 8
    s_add_u32 s60, s60, 161536
    v_lshl_add_u32 v28, v1, 2, s60
    s_lshl_b32 s34, s48, 7
    s_add_u32 s34, s34, 163072
    v_add_u32 v5, s34, v5
    v_lshrrev_b32 v6, 5, v1
    v_lshl_add_u32 v6, v6, 6, s34
    v_mov_b32 v7, 2048
    s_barrier
    s_waitcnt vmcnt(0)
    v_cmp_gt_i32 s[54:55], 1, v63
    v_min_i32 v63, v63, v7
    s_nop 0
    v_cndmask_b32 v63, v63, v7, s[54:55]
    v_add_u32 v63, 15, v63
    v_lshrrev_b32 v63, 4, v63
    v_lshl_or_b32 v19, v63, 5, v2
    ds_write_b32 v5, v19
    ds_read_b128 v[64:67], v6 offset:0
    ds_read_b128 v[68:71], v6 offset:16
    ds_read_b128 v[72:75], v6 offset:32
    ds_read_b128 v[76:79], v6 offset:48
    v_mov_b32 v20, 0
    v_readlane_b32 s39, v63, s28
    s_waitcnt lgkmcnt(0)
    v_sub_u32 v64, v64, v19
    v_sub_u32 v65, v65, v19
    v_sub_u32 v66, v66, v19
    v_sub_u32 v67, v67, v19
    v_sub_u32 v68, v68, v19
    v_sub_u32 v69, v69, v19
    v_sub_u32 v70, v70, v19
    v_sub_u32 v71, v71, v19
    v_sub_u32 v72, v72, v19
    v_sub_u32 v73, v73, v19
    v_sub_u32 v74, v74, v19
    v_sub_u32 v75, v75, v19
    v_sub_u32 v76, v76, v19
    v_sub_u32 v77, v77, v19
    v_sub_u32 v78, v78, v19
    v_sub_u32 v79, v79, v19
    v_alignbit_b32 v20, v20, v64, 31
    v_alignbit_b32 v20, v20, v65, 31
    v_alignbit_b32 v20, v20, v66, 31
    v_alignbit_b32 v20, v20, v67, 31
    v_alignbit_b32 v20, v20, v68, 31
    v_alignbit_b32 v20, v20, v69, 31
    v_alignbit_b32 v20, v20, v70, 31
    v_alignbit_b32 v20, v20, v71, 31
    v_alignbit_b32 v20, v20, v72, 31
    v_alignbit_b32 v20, v20, v73, 31
    v_alignbit_b32 v20, v20, v74, 31
    v_alignbit_b32 v20, v20, v75, 31
    v_alignbit_b32 v20, v20, v76, 31
    v_alignbit_b32 v20, v20, v77, 31
    v_alignbit_b32 v20, v20, v78, 31
    v_alignbit_b32 v20, v20, v79, 31
    v_bcnt_u32_b32 v20, v20, 0
    v_mov_b32 v4, v20
    s_add_u32 s40, s39, 1
    s_lshr_b32 s40, s40, 1
    s_sub_u32 s41, s40, 1
    s_min_u32 s41, s41, 4
    v_permlane32_swap_b32 v20, v4
    s_nop 0
    v_add_u32 v20, v20, v4
    s_nop 0
    v_readlane_b32 s80, v20, s28
    s_sub_u32 s32, 31, s80
    v_cmp_eq_u32 vcc, s32, v20
    s_ff1_i32_b32 s81, vcc_lo
    v_readlane_b32 s82, v63, s81
    s_max_u32 s32, s39, s82
    s_min_u32 s33, s39, s82
    s_sub_u32 s83, s32, s33
    s_add_u32 s83, s83, 2
    s_lshr_b32 s83, s83, 2
    s_cmp_lt_u32 s32, 24
    s_cselect_b32 s83, 0, s83
    s_cmp_ge_u32 s80, 16
    s_cselect_b32 s92, s83, 0
    s_cselect_b32 s85, 0, s83
    s_cmp_eq_u32 s48, 0
    s_cbranch_scc1 L_pl_norow
    s_lshl_b32 s32, s81, 9
    v_lshl_add_u32 v3, v1, 3, s32
    global_load_dwordx2 v[8:9], v3, s[10:11]
L_pl_norow:
    s_sub_u32 s84, s40, s92
    s_add_u32 s42, s84, s85
    s_mul_i32 s86, s42, 40
    s_lshr_b32 s86, s86, 6
    s_min_u32 s87, s84, 8
    s_sub_i32 s86, s86, s87
    s_max_i32 s86, s86, s85
    s_max_i32 s86, s86, 1
    v_cvt_f32_u32 v4, s86
    v_subrev_u32 v5, s87, v1
    v_rcp_f32 v4, v4
    v_mul_i32_i24 v6, s85, v5
    v_add_u32 v7, s85, v6
    v_cvt_f32_i32 v6, v6
    v_cvt_f32_i32 v7, v7
    v_add_f32 v6, 0.5, v6
    v_add_f32 v7, 0.5, v7
    v_mul_f32 v6, v6, v4
    v_mul_f32 v7, v7, v4
    v_floor_f32 v6, v6
    v_floor_f32 v7, v7
    v_cmp_gt_u32 vcc, s86, v5
    v_cmp_gt_f32 s[90:91], v7, v6
    s_sub_u32 s32, s42, s41
    v_subrev_u32 v5, s41, v1
    v_cmp_gt_u32 s[88:89], s32, v5
    s_and_b64 s[90:91], s[90:91], vcc
    s_andn2_b64 s[88:89], s[88:89], s[90:91]
    s_ff1_i32_b64 s34, s[88:89]
    s_lshl_b32 s34, s34, 8
    s_or_b32 s87, s34, 1
    s_min_u32 s52, s92, 1
    s_add_u32 s92, s92, s41
    s_sub_u32 s93, s40, s92
    s_sub_u32 s35, s40, 1
    s_mov_b32 s94, 162048
    s_cmp_eq_u32 s48, 0
    s_cbranch_scc1 L_pl_a
    s_mov_b32 s92, 4
    s_mov_b32 s93, s85
    s_mov_b32 s35, -1
    s_mov_b32 s94, 162560
    s_mov_b64 s[88:89], s[90:91]
    s_branch L_pl_sort
L_pl_a:
    s_lshl_b32 s32, s42, 8
    s_or_b32 s32, s32, s52
    v_mov_b32 v4, s88
    v_mov_b32 v5, s89
    v_mov_b32 v6, s32
    v_mov_b32 v7, s87
    v_mov_b32 v3, 160640
    ds_write_b128 v3, v[4:7]
L_pl_sort:
    v_subrev_u32 v2, s92, v1
    v_cmp_gt_u32 vcc, s93, v2
    v_mov_b32 v7, 1
    s_waitcnt vmcnt(0)
    v_lshrrev_b32 v2, 6, v8
    v_lshrrev_b32 v3, 6, v9
    v_cmp_eq_u32 s[82:83], s35, v1
    v_med3_u32 v2, v2, 1, 63
    v_med3_u32 v3, v3, 1, 63
    v_cndmask_b32 v2, v2, 0, s[82:83]
    v_cndmask_b32 v3, v3, 0, s[82:83]
    v_lshlrev_b32 v2, 2, v2
    v_lshlrev_b32 v3, 2, v3
    v_add_u32 v64, s60, v2
    v_add_u32 v65, s60, v3
    s_mov_b64 exec, vcc
    ds_add_rtn_u32 v4, v64, v7
    ds_add_rtn_u32 v5, v65, v7
    s_mov_b64 exec, -1
    ds_read_b32 v6, v28
    s_waitcnt lgkmcnt(0)
    v_mov_b32 v66, v6
    s_nop 1
    v_add_u32_dpp v6, v6, v6 row_shr:1 row_mask:0xf bank_mask:0xf bound_ctrl:0
    s_nop 1
    v_add_u32_dpp v6, v6, v6 row_shr:2 row_mask:0xf bank_mask:0xf bound_ctrl:0
    s_nop 1
    v_add_u32_dpp v6, v6, v6 row_shr:4 row_mask:0xf bank_mask:0xf bound_ctrl:0
    s_nop 1
    v_add_u32_dpp v6, v6, v6 row_shr:8 row_mask:0xf bank_mask:0xf bound_ctrl:0
    s_nop 1
    v_add_u32_dpp v6, v6, v6 row_bcast:15 row_mask:0xa bank_mask:0xf
    s_nop 1
    v_add_u32_dpp v6, v6, v6 row_bcast:31 row_mask:0xc bank_mask:0xf
    v_sub_u32 v6, v6, v66
    ds_bpermute_b32 v2, v2, v6
    ds_bpermute_b32 v3, v3, v6
    s_waitcnt lgkmcnt(0)
    v_add_u32 v4, v4, v2
    v_add_u32 v5, v5, v3
    v_lshlrev_b32 v8, 15, v8
    v_lshlrev_b32 v9, 15, v9
    v_lshl_add_u32 v4, v4, 2, s94
    v_lshl_add_u32 v5, v5, 2, s94
    s_mov_b64 exec, vcc
    ds_write_b32 v4, v8
    ds_write_b32 v5, v9
    s_mov_b64 exec, -1
    v_mbcnt_lo_u32_b32 v2, s88, 0
    v_mbcnt_hi_u32_b32 v2, s89, v2
    v_lshl_add_u32 v2, v2, 3, s94
    ds_read_b64 v[4:5], v2
    s_lshr_b32 s32, s87, 8
    s_sub_u32 s33, s42, 1
    v_cmp_eq_u32 vcc, s32, v1
    v_cmp_eq_u32 s[82:83], s33, v1
    v_cmp_eq_u32 s[34:35], 49, v1
    v_cndmask_b32 v6, 1, 3, vcc
    v_cndmask_b32 v7, 0, 12, s[82:83]
    v_cndmask_b32 v3, 0, 4, s[34:35]
    v_or3_b32 v6, v6, v7, v3
    v_lshlrev_b32 v2, 3, v1
    v_add_u32 v2, 160768, v2
    s_waitcnt lgkmcnt(0)
    v_or_b32 v4, v4, v6
    s_mov_b64 exec, s[88:89]
    ds_write_b64 v2, v[4:5]
    s_mov_b64 exec, -1
L_pl_done:
    s_cmp_lg_u32 s52, 0
    s_cbranch_scc1 L_fetch
    s_cmp_eq_u32 s85, 0
    s_cbranch_scc1 L_fin
    s_lshl3_add_u32 s58, s81, s29
    s_lshl1_add_u32 s58, s58, s48
    s_lshl_b32 s58, s58, 12
    v_and_b32 v2, 15, v1
    v_lshrrev_b32 v60, 4, v1
    v_lshl_add_u32 v6, v2, 8, s58
    v_lshl_add_u32 v6, v60, 4, v6
    global_load_dwordx4 v[32:35], v6, s[4:5] offset:0
    global_load_dwordx4 v[36:39], v6, s[4:5] offset:64
    global_load_dwordx4 v[40:43], v6, s[4:5] offset:128
    global_load_dwordx4 v[44:47], v6, s[4:5] offset:192
    s_mov_b64 s[24:25], s[90:91]
    s_mov_b32 s46, s90
    s_and_b32 s47, s91, 0x3ffff
    s_mov_b32 s23, s42
    s_min_u32 s22, s42, 50
    s_mov_b32 s57, 1
    s_mov_b32 s59, 1
    s_lshr_b32 s35, s54, s81
    s_and_b32 s35, s35, 1
    s_branch L_csetup
L_fetch:
    s_cmp_lg_u32 s48, 0
    s_cbranch_scc1 L_fin
    s_lshl3_add_u32 s58, s28, s29
    s_lshl1_add_u32 s58, s58, s48
    s_lshl_b32 s58, s58, 12
    v_and_b32 v2, 15, v1
    v_lshrrev_b32 v60, 4, v1
    v_lshl_add_u32 v6, v1, 7, s58
    global_load_dword v61, v6, s[14:15]
    s_lshl3_add_u32 s32, s28, s29
    s_lshl_b32 s32, s32, 9
    v_lshl_add_u32 v3, v2, 3, s32
    v_mov_b32 v29, s32
    s_lshl_b32 s34, s28, 2
    v_mov_b32 v4, s34
    v_mov_b32 v28, 160016
    s_mov_b64 exec, 1
    s_mul_i32 s51, s42, 55
    s_lshr_b32 s51, s51, 5
    s_lshl_b32 s35, s29, 1
    s_mov_b32 s50, 0
L_f_wait:
    ds_read_b64 v[30:31], v28
    s_waitcnt lgkmcnt(0)
    v_readfirstlane_b32 s49, v30
    v_readfirstlane_b32 s32, v31
    s_cmp_ge_i32 s49, s51
    s_cselect_b32 s32, s32, 0
    s_cmp_lg_u32 s32, 0
    s_cbranch_scc1 L_f_poll
    s_sleep 8
    s_sub_u32 s38, s38, 1
    s_cbranch_scc0 L_f_wait
    s_endpgm
L_f_poll:
    global_load_dwordx2 v[30:31], v29, s[18:19] offset:256 sc1
    s_add_u32 s50, s50, 1
    s_and_b32 s32, s50, 3
    s_mov_b32 s34, 0
    s_cbranch_scc1 L_f_nodbg
    global_load_dword v5, v4, s[16:17] sc1
    s_waitcnt vmcnt(0)
    v_readfirstlane_b32 s34, v5
    s_lshr_b32 s34, s34, s35
L_f_nodbg:
    s_waitcnt vmcnt(0)
    v_lshl_or_b32 v30, v31, 1, v30
    s_nop 0
    v_readfirstlane_b32 s32, v30
    s_or_b32 s32, s32, s34
    s_and_b32 s32, s32, 3
    s_cmp_eq_u32 s32, 3
    s_cbranch_scc1 L_f_got
    s_sleep 6
    s_sub_u32 s38, s38, 1
    s_cbranch_scc0 L_f_poll
    s_endpgm
L_f_got:
    s_mov_b64 exec, -1
    s_and_b32 s34, s34, 3
    s_cbranch_scc0 L_f_ld
    buffer_inv sc1
    s_waitcnt vmcnt(0)
L_f_ld:
    v_lshl_add_u32 v6, v1, 4, s58
    v_add_u32 v7, 4096, v6
    global_load_dwordx2 v[24:25], v3, s[18:19] offset:0 sc1
    global_load_dwordx4 v[64:67], v6, s[14:15] offset:0 sc1
    global_load_dwordx4 v[68:71], v6, s[14:15] offset:1024 sc1
    global_load_dwordx4 v[72:75], v6, s[14:15] offset:2048 sc1
    global_load_dwordx4 v[76:79], v6, s[14:15] offset:3072 sc1
    global_load_dwordx2 v[26:27], v3, s[18:19] offset:128 sc1
    global_load_dwordx4 v[80:83], v7, s[14:15] offset:0 sc1
    global_load_dwordx4 v[84:87], v7, s[14:15] offset:1024 sc1
    global_load_dwordx4 v[88:91], v7, s[14:15] offset:2048 sc1
    global_load_dwordx4 v[92:95], v7, s[14:15] offset:3072 sc1
    v_lshlrev_b32 v4, 4, v1
    v_add_u32 v4, 151552, v4
    v_lshlrev_b32 v2, 3, v2
    v_add_u32 v2, 151552, v2
    v_mov_b32 v30, 160004
    v_mov_b32 v5, 1
    s_waitcnt vmcnt(5)
    ds_write_b128 v4, v[64:67] offset:0
    ds_write_b128 v4, v[68:71] offset:1024
    ds_write_b128 v4, v[72:75] offset:2048
    ds_write_b128 v4, v[76:79] offset:3072
    ds_write_b64 v2, v[24:25] offset:4096
    ds_write_b32 v30, v5 offset:0
    s_waitcnt vmcnt(0)
    ds_write_b128 v4, v[80:83] offset:4224
    ds_write_b128 v4, v[84:87] offset:5248
    ds_write_b128 v4, v[88:91] offset:6272
    ds_write_b128 v4, v[92:95] offset:7296
    ds_write_b64 v2, v[26:27] offset:8320
    ds_write_b32 v30, v5 offset:8
    s_endpgm
L_ctl:
    v_mov_b32 v3, 160640
    v_mov_b32 v28, 160032
    v_mov_b32 v29, 160656
    s_lshl_b32 s32, s28, 2
    v_mov_b32 v60, s32
    v_mov_b32 v62, v5
    s_getreg_b32 s32, hwreg(HW_REG_XCC_ID, 0, 3)
    s_mov_b32 s46, 0xf501f507
    s_mov_b32 s47, 0xf608f706
    s_lshl_b32 s32, s32, 3
    s_lshr_b64 s[46:47], s[46:47], s32
    s_sext_i32_i8 s56, s46
    s_and_b32 s32, s29, 3
    s_cmp_eq_u32 s32, 1
    s_cselect_b32 s32, 13, 0
    s_add_u32 s56, s56, s32
L_g_plan:
    ds_read_b128 v[4:7], v3
    s_waitcnt lgkmcnt(0)
    v_readfirstlane_b32 s32, v7
    v_readfirstlane_b32 s42, v6
    s_cmp_lg_u32 s32, 0
    s_cbranch_scc1 L_g_go
    s_sleep 8
    s_sub_u32 s38, s38, 1
    s_cbranch_scc0 L_g_plan
    s_endpgm
L_g_go:
    s_and_b32 s52, s42, 1
    s_cbranch_scc0 L_g_nores
    s_lshl3_add_u32 s32, s28, s29
    s_lshl_b32 s32, s32, 9
    v_mov_b32 v2, s32
    v_mov_b32 v4, 0
    v_mov_b32 v5, 0
    v_mov_b32 v6, 160020
    v_mov_b32 v7, 1
    s_mov_b64 exec, 1
    global_store_dwordx2 v2, v[4:5], s[18:19] offset:256
    s_waitcnt vmcnt(0)
    ds_write_b32 v6, v7
    s_mov_b64 exec, -1
L_g_nores:
    s_and_b32 s32, s16, 127
    s_cbranch_scc1 L_fin
    s_getreg_b32 s99, hwreg(HW_REG_XCC_ID, 0, 4)
    s_lshl4_add_u32 s99, s52, s99
    s_lshl4_add_u32 s99, s99, s29
    s_lshl_b32 s99, s99, 16
    s_lshr_b32 s42, s42, 8
    s_lshl1_add_u32 s96, s42, 1
    v_lshlrev_b32 v3, 1, v62
    v_add_u32 v3, 160068, v3
    v_mov_b32 v4, s99
    s_mov_b64 exec, 1
    global_store_dword v60, v4, s[16:17] offset:128
    s_mov_b64 exec, -1
    s_mov_b32 s51, 8
L_g_next:
    s_sub_u32 s32, s96, s51
    s_cmp_lt_i32 s32, 4
    s_cbranch_scc1 L_fin
L_g_w:
    ds_read_b32 v30, v28
    s_waitcnt lgkmcnt(0)
    v_readfirstlane_b32 s49, v30
    s_cmp_ge_i32 s49, s51
    s_cbranch_scc1 L_g_a
    s_sleep 1
    s_sub_u32 s38, s38, 1
    s_cbranch_scc0 L_g_w
    s_endpgm
L_g_a:
    s_sub_u32 s97, s96, s49
    s_or_b32 s32, s97, s99
    v_mov_b32 v4, s32
    s_mov_b64 exec, 1
    global_store_dword v60, v4, s[16:17] offset:128
    s_mov_b64 exec, -1
    global_load_dword v2, v62, s[16:17] offset:128 sc1
    s_add_u32 s51, s49, 3
    s_min_i32 s35, s56, 1
    s_max_i32 s35, s35, -1
    s_sub_u32 s56, s56, s35
    s_waitcnt vmcnt(0)
    ds_write_b32 v3, v2
    v_and_b32 v2, 0xffff, v2
    v_cmp_ne_u32 vcc, 0, v2
    s_nop 1
    v_add_u32_dpp v2, v2, v2 row_shr:1 row_mask:0xf bank_mask:0xf bound_ctrl:0
    s_nop 1
    v_add_u32_dpp v2, v2, v2 row_shr:2 row_mask:0xf bank_mask:0xf bound_ctrl:0
    s_nop 1
    v_add_u32_dpp v2, v2, v2 row_shr:4 row_mask:0xf bank_mask:0xf bound_ctrl:0
    s_nop 1
    v_add_u32_dpp v2, v2, v2 row_shr:8 row_mask:0xf bank_mask:0xf bound_ctrl:0
    s_nop 1
    v_add_u32_dpp v2, v2, v2 row_bcast:15 row_mask:0xa bank_mask:0xf
    s_bcnt1_i32_b32 s33, vcc_lo
    v_readlane_b32 s32, v2, 31
    s_mul_i32 s34, s97, s33
    s_sub_u32 s34, s34, s32
    s_lshl_b32 s34, s34, 2
    s_mul_i32 s32, s33, -9
    s_cmp_lt_i32 s34, s32
    s_cselect_b32 s32, -1, 0
    s_add_u32 s35, s35, s32
    s_mul_i32 s32, s33, -5
    s_cmp_gt_i32 s34, s32
    s_cselect_b32 s32, 1, 0
    s_add_u32 s35, s35, s32
    s_mul_i32 s32, s33, -2
    s_cmp_gt_i32 s34, s32
    s_cselect_b32 s32, 1, 0
    s_add_u32 s35, s35, s32
    s_max_i32 s35, s35, -1
    s_min_i32 s35, s35, 2
    v_mov_b32 v4, s35
    ds_write_b32 v29, v4
    s_branch L_g_next
L_fin:
L_end:
    s_endpgm
.section .rodata,"a"
.p2align 6
.amdhsa_kernel standalone__paged_block_table_kv_pagedattention__sampling_kernel
  .amdhsa_next_free_vgpr 168
  .amdhsa_next_free_sgpr 102
  .amdhsa_accum_offset 168
  .amdhsa_group_segment_fixed_size 0
  .amdhsa_kernarg_size 64
  .amdhsa_user_sgpr_count 2
  .amdhsa_user_sgpr_kernarg_segment_ptr 1
  .amdhsa_system_sgpr_workgroup_id_x 1
  .amdhsa_float_denorm_mode_32 3
.end_amdhsa_kernel
```
